```python
import torch

def _softmax(x, axis=-1):
    return torch.softmax(x, dim=axis)
def _gelu(x):
    return torch.nn.functional.gelu(x, approximate="tanh")
def _silu(x):
    return torch.nn.functional.silu(x)
def _sigmoid(x):
    return torch.sigmoid(x)
def _layernorm(x, axis=-1, eps=1e-5):
    m = x.mean(dim=axis, keepdim=True)
    v = x.var(dim=axis, keepdim=True, unbiased=False)
    return (x - m) / torch.sqrt(v + eps)
def _scatter_add(tgt, idx, src, axis=0):
    return tgt.clone().index_add_(axis, idx, src)
def _segment_sum(src, seg, n):
    out = torch.zeros((n,) + src.shape[1:], dtype=src.dtype)
    return out.index_add_(0, seg, src)
def _pad(x, pw):
    flat = tuple(v for pair in reversed(pw) for v in pair)
    return torch.nn.functional.pad(x, flat)

kernel_name = 'sequential_preLN__sliding_block_cached__mixer_token_mlp__decode'

def setup_inputs():

    _w = (lambda a: (lambda t: t.to(torch.bfloat16) if t.is_floating_point() else t)(torch.as_tensor(a)))
    def _A_setup():
        B, Sq, D = 1, 1, 448
        Hq, Hkv, Sk, Dh = 16, 8, 65536, 256
        assert Hq % Hkv == 0, (Hq, Hkv)
        return {
            "x": _w((lambda *s: torch.randn(*s, dtype=torch.bfloat16) * 0.05)(B, Sq, D)),
            "k_cache": _w((lambda *s: torch.randn(*s, dtype=torch.bfloat16) * 3.2)(B, Hkv, Sk, Dh)),
            "v_cache": _w((lambda *s: torch.randn(*s, dtype=torch.bfloat16) * 0.8)(B, Hkv, Sk, Dh)),
            "wq": _w((lambda *s: torch.randn(*s, dtype=torch.bfloat16) * 3.2)(D, Hq * Dh) * (D ** -0.5)),
            "wo": _w((lambda *s: torch.randn(*s, dtype=torch.bfloat16) * 0.8)(Hq * Dh, D) * ((Hq * Dh) ** -0.5)),
        }
    _A_in = _A_setup()

    def _B_setup():
        B, S, D, F = 1, 1, 448, 1792
        return {
            "x": _w((lambda *s: torch.randn(*s, dtype=torch.bfloat16) * 0.05)(B, S, D)),
            "w1": _w((lambda *s: torch.randn(*s, dtype=torch.bfloat16) * 3.2)(S, F) * (S ** -0.5)),
            "b1": _w((lambda *s: torch.randn(*s, dtype=torch.bfloat16) * 3.2)(F) * 0.02),
            "w2": _w((lambda *s: torch.randn(*s, dtype=torch.bfloat16) * 0.4)(F, S) * (F ** -0.5)),
            "b2": _w((lambda *s: torch.randn(*s, dtype=torch.bfloat16) * 0.4)(S) * 0.02),
        }
    _B_in = _B_setup()

    return {
        "A_x": _A_in["x"],
        "A_k_cache": _A_in["k_cache"],
        "A_v_cache": _A_in["v_cache"],
        "A_wq": _A_in["wq"],
        "A_wo": _A_in["wo"],
        "B_x": _B_in["x"],
        "B_w1": _B_in["w1"],
        "B_b1": _B_in["b1"],
        "B_w2": _B_in["w2"],
        "B_b2": _B_in["b2"],
    }

def reference(A_x, A_k_cache, A_v_cache, A_wq, A_wo, B_x, B_w1, B_b1, B_w2, B_b2):
    def _A_ref(x, k_cache, v_cache, wq, wo):
        B, Sq, D = x.shape
        Hq, Dh = 16, 256
        Hkv, Sk = k_cache.shape[1], k_cache.shape[2]
        W = min(4096, max(256, Sk // 4))
        rep = Hq // Hkv
        q = (lambda x, *d: x.permute(*d))((x @ wq).reshape(B, Sq, Hq, Dh), 0, 2, 1, 3)
        k = (lambda x, n, axis: torch.repeat_interleave(x, n, dim=axis))(k_cache[:, :, Sk - W:, :], rep, axis=1)
        v = (lambda x, n, axis: torch.repeat_interleave(x, n, dim=axis))(v_cache[:, :, Sk - W:, :], rep, axis=1)
        scores = torch.einsum("bhqd,bhkd->bhqk", q, k) * (Dh ** -0.5)
        p = _softmax(scores, axis=-1)
        o = torch.einsum("bhqk,bhkd->bhqd", p, v)
        return (lambda x, *d: x.permute(*d))(o, 0, 2, 1, 3).reshape(B, Sq, Hq * Dh) @ wo

    def _B_ref(x, w1, b1, w2, b2):
        B, S, D = x.shape
        h = _layernorm(x, axis=-1)
        u = torch.einsum("bsd,sf->bdf", h, w1) + b1
        u = _gelu(u)
        y = torch.einsum("bdf,fs->bds", u, w2) + b2
        return (lambda x, *d: x.permute(*d))(y, 0, 2, 1)

    x = A_x
    h = x + _A_ref(_layernorm(x, axis=-1), A_k_cache, A_v_cache, A_wq, A_wo)
    h2 = h + _B_ref(_layernorm(h, axis=-1), B_w1, B_b1, B_w2, B_b2)
    return h2
```

```asm
; @launch grid=(256,1,1) block=(832,1,1) lds=148512
.amdgcn_target "amdgcn-amd-amdhsa--gfx950"
.text
.globl sequential_preLN__sliding_block_cached__mixer_token_mlp__decode_kernel
.p2align 8
.type sequential_preLN__sliding_block_cached__mixer_token_mlp__decode_kernel,@function
sequential_preLN__sliding_block_cached__mixer_token_mlp__decode_kernel:
    v_lshrrev_b32 v2, 6, v0
    s_cmp_ge_u32 s2, 256
    s_cbranch_scc1 L_end
    s_load_dwordx16 s[4:19], s[0:1], 0
    s_load_dwordx8 s[20:27], s[0:1], 64
    s_load_dwordx2 s[28:29], s[0:1], 96
    v_readfirstlane_b32 s32, v2
    v_and_b32 v1, 63, v0
    s_and_b32 s30, s2, 7
    s_lshr_b32 s31, s2, 3
    s_cmp_eq_u32 s32, 0
    s_cbranch_scc0 L_kv
    s_getpc_b64 s[72:73]
L_pc:
    s_sub_u32 s72, s72, L_pc-sequential_preLN__sliding_block_cached__mixer_token_mlp__decode_kernel
    s_subb_u32 s73, s73, 0
    v_lshl_add_u32 v24, s31, 3, v1
    v_lshlrev_b32 v24, 6, v24
    v_min_u32 v24, L_codeend-4-sequential_preLN__sliding_block_cached__mixer_token_mlp__decode_kernel, v24
    s_mov_b64 exec, 0xff
    global_load_dword v107, v24, s[72:73]
    s_mov_b64 exec, -1
    v_lshlrev_b32 v15, 2, v1
    v_add_u32 v2, 147840, v15
    v_mov_b32 v4, 0
    ds_write_b32 v2, v4
    v_cmp_gt_u32 vcc, 2, v1
    v_mov_b32 v5, 0xff800000
    v_lshrrev_b32 v6, 3, v1
    v_and_b32 v3, 7, v1
    v_cndmask_b32 v4, v4, v5, vcc
    s_mov_b64 exec, 0xfff
    ds_write_b32 v2, v4 offset:256
    s_mov_b64 exec, -1
    s_lshr_b32 s36, s31, 3
    s_mul_i32 s36, s36, 224
    v_mul_u32_u24 v23, 28, v6
    v_add_u32 v23, s36, v23
    v_lshlrev_b32 v5, 4, v1
    s_waitcnt lgkmcnt(0)
    s_mov_b32 s6, 896
    s_mov_b32 s7, 0x20000
    buffer_load_dwordx4 v[16:19], v5, s[4:7], 0 offen
    global_load_dwordx4 v[8:11], v23, s[4:5]
    global_load_dwordx3 v[12:14], v23, s[4:5] offset:16
    s_barrier
    s_branch L_svc
L_kv:
    s_cmp_gt_u32 s32, 4
    s_cbranch_scc0 L_ld
    s_barrier
    s_branch L_cw
L_ld:
    s_lshl_b32 s32, s32, 1
    s_sub_u32 s32, s32, 2
    s_lshl_b32 s62, s32, 10
    s_and_b32 s44, s31, 7
    s_lshl_b32 s44, s44, 13
    s_mov_b32 s46, s30
    s_lshl_b32 s46, s46, 10
    s_mov_b32 m0, s62
    v_lshrrev_b32 v2, 5, v1
    v_and_b32 v3, 31, v1
    v_lshl_add_u32 v2, s32, 1, v2
    v_xor_b32 v4, v3, v2
    v_lshlrev_b32 v4, 4, v4
    v_lshl_add_u32 v4, v2, 9, v4
    v_xor_b32 v4, s46, v4
    v_xor_b32 v6, 0x420, v4
    s_lshl_b32 s34, s30, 25
    s_lshl_b32 s35, s31, 16
    s_add_u32 s34, s34, s35
    s_add_u32 s34, s34, 0x1E00000
    s_mov_b32 s38, 0x10000
    s_mov_b32 s39, 0x20000
    v_lshrrev_b32 v8, 3, v1
    v_mul_u32_u24 v8, 114688, v8
    v_and_b32 v9, 7, v1
    v_lshl_add_u32 v8, v9, 4, v8
    s_lshr_b32 s40, s31, 3
    s_mul_i32 s40, s40, 917504
    s_and_b32 s35, s31, 7
    s_lshl_b32 s35, s35, 7
    s_add_u32 s40, s40, s35
    s_lshl_b32 s35, s30, 10
    s_add_u32 s40, s40, s35
    s_mov_b32 s42, 909440
    s_mov_b32 s43, 0x20000
    s_lshl_b32 s35, s32, 14
    s_lshl_b32 s33, s62, 1
    s_add_u32 m0, s33, 131072
    v_mov_b32 v22, 148104
    v_mov_b32 v23, 1
    s_waitcnt lgkmcnt(0)
    s_add_u32 s40, s10, s40
    s_addc_u32 s41, s11, 0
    s_add_u32 s36, s6, s34
    s_addc_u32 s37, s7, 0
    buffer_load_dwordx4 v8, s[40:43], s35 offen nt lds
    s_add_u32 m0, m0, 0x400
    s_add_u32 s35, s35, 0x2000
    buffer_load_dwordx4 v8, s[40:43], s35 offen nt lds
    s_cmp_eq_u32 s32, 6
    s_cbranch_scc1 L_w2
    s_add_u32 m0, m0, 0x400
    s_add_u32 s35, s35, 0x2000
    buffer_load_dwordx4 v8, s[40:43], s35 offen nt lds
    s_add_u32 m0, m0, 0x400
    s_add_u32 s35, s35, 0x2000
    buffer_load_dwordx4 v8, s[40:43], s35 offen nt lds
L_w2:
    s_mov_b32 m0, s62
    s_mov_b32 s35, 0
    s_barrier
L_kl:
    s_cmp_eq_u32 s35, 32768
    s_cbranch_scc0 L_kn
    s_waitcnt vmcnt(8)
    s_mov_b64 exec, 1
    ds_add_u32 v22, v23 offset:20
    s_mov_b64 exec, -1
L_kn:
    s_cmp_lt_u32 s35, 32768
    s_cbranch_scc1 L_kw
    s_waitcnt vmcnt(6)
L_kw:
    s_xor_b32 s45, s35, s44
    buffer_load_dwordx4 v4, s[36:39], s45 offen nt lds
    s_add_u32 m0, m0, 0x400
    s_nop 0
    buffer_load_dwordx4 v6, s[36:39], s45 offen nt lds
    s_add_u32 s35, s35, 0x2000
    s_add_u32 m0, m0, 0x1c00
    s_cmp_lt_u32 s35, 0x10000
    s_cbranch_scc1 L_kl
    s_add_u32 s36, s8, s34
    s_addc_u32 s37, s9, 0
    v_and_b32 v5, 7, v2
    v_lshlrev_b32 v5, 1, v5
    v_xor_b32 v5, v3, v5
    v_lshlrev_b32 v5, 4, v5
    v_lshl_add_u32 v5, v2, 9, v5
    v_xor_b32 v5, s46, v5
    v_xor_b32 v7, 0x440, v5
    v_mov_b32 v22, 148104
    v_mov_b32 v23, 1
    s_mov_b32 s35, 0
    s_mov_b32 s33, 0
L_vp:
    s_cmp_eq_u32 s35, 0
    s_cbranch_scc0 L_vg
    s_mov_b64 exec, 1
    ds_add_u32 v22, v23 offset:28
    s_mov_b64 exec, -1
L_vg:
    ds_read_b32 v21, v22 offset:4
    s_cmp_lg_u32 s33, 0
    s_cbranch_scc1 L_vn
    s_waitcnt vmcnt(6)
L_vn:
    s_xor_b32 s45, s35, s44
    buffer_load_dwordx4 v5, s[36:39], s45 offen nt lds
    s_add_u32 m0, m0, 0x400
    s_nop 0
    buffer_load_dwordx4 v7, s[36:39], s45 offen nt lds
    s_add_u32 s35, s35, 0x2000
    s_add_u32 m0, m0, 0x1c00
    s_cmp_eq_u32 s35, 32768
    s_cbranch_scc0 L_vk
    s_waitcnt vmcnt(8)
    s_mov_b64 exec, 1
    ds_add_u32 v22, v23 offset:8
    s_mov_b64 exec, -1
L_vk:
    s_waitcnt lgkmcnt(0)
    v_readfirstlane_b32 s33, v21
    s_cmp_lt_u32 s35, 0x10000
    s_cbranch_scc1 L_vp
    s_lshl_b32 s34, s30, 9
    s_lshl_b32 s35, s31, 4
    s_add_u32 s34, s34, s35
    s_mul_i32 s34, s34, 896
    s_add_u32 s36, s12, s34
    s_addc_u32 s37, s13, 0
    s_mov_b32 s38, 14336
    v_lshrrev_b32 v18, 3, v1
    v_mul_u32_u24 v18, 896, v18
    v_and_b32 v21, 7, v1
    v_lshl_add_u32 v18, v21, 4, v18
    v_lshl_add_u32 v18, s32, 7, v18
    s_cmp_eq_u32 s32, 6
    s_cselect_b32 s34, 0, 128
    s_cselect_b32 s35, 0, 0x800
    v_add_u32 v19, s34, v18
    s_lshl_b32 s62, s62, 1
    s_add_u32 s62, s62, 131072
    s_movk_i32 s63, 7168
L_wq:
    ds_read_b32 v21, v22 offset:4
    s_waitcnt lgkmcnt(0)
    v_readfirstlane_b32 s33, v21
    s_nop 0
    s_cmp_eq_u32 s33, 0
    s_cbranch_scc1 L_wq
    s_mov_b32 m0, s62
    s_add_u32 s35, s35, s62
    buffer_load_dwordx4 v18, s[36:39], 0 offen nt lds
    s_add_u32 m0, m0, 0x400
    s_nop 0
    buffer_load_dwordx4 v18, s[36:39], s63 offen nt lds
    s_mov_b32 m0, s35
    s_nop 0
    buffer_load_dwordx4 v19, s[36:39], 0 offen nt lds
    s_add_u32 m0, m0, 0x400
    s_nop 0
    buffer_load_dwordx4 v19, s[36:39], s63 offen nt lds
    s_waitcnt vmcnt(8)
    s_barrier
    s_waitcnt vmcnt(4)
    s_barrier
    s_barrier
    s_waitcnt vmcnt(0)
    s_mov_b64 exec, 1
    ds_add_u32 v22, v23 offset:8
    s_endpgm
L_cw:
    s_cmp_ge_u32 s32, 6
    s_cbranch_scc1 L_nr
    s_mov_b32 s34, s2
    s_lshr_b32 s35, s34, 6
    s_lshl_b32 s35, s35, 14
    s_and_b32 s34, s34, 63
    s_lshl_b32 s34, s34, 7
    s_add_u32 s34, s34, s35
    s_add_u32 s34, s34, 917504
    s_add_u32 s35, s34, 0x2000
    s_waitcnt lgkmcnt(0)
    s_load_dword s37, s[28:29], s35
    s_load_dwordx2 s[38:39], s[28:29], s34
L_nr:
    s_sub_u32 s32, s32, 5
    s_cmp_ge_u32 s32, 1
    s_cbranch_scc1 L_nr2
    s_waitcnt lgkmcnt(2)
    s_getreg_b32 s40, hwreg(HW_REG_IB_STS, 8, 4)
    s_cmp_eq_u32 s40, 2
    s_cselect_b32 s40, 1, 0
    v_mov_b32 v2, 148104
    v_mov_b32 v3, s40
    s_mov_b64 exec, 1
    ds_add_u32 v2, v3 offset:24
    s_mov_b64 exec, -1
L_nr2:
    s_waitcnt lgkmcnt(0)
    s_load_dword s33, s[28:29], 0
    s_branch L_kv2
L_svc:
    s_setprio 3
    s_load_dword s33, s[28:29], 0
    s_lshl_b32 s34, s30, 14
    s_add_u32 s34, s34, 65536
    s_add_u32 s60, s28, s34
    s_addc_u32 s61, s29, 0
    s_mov_b32 s62, 0x24000
    s_mov_b32 s63, 0x20000
    s_lshl_b32 s34, s31, 8
    s_add_u32 s58, s60, s34
    s_addc_u32 s59, s61, 0
    s_lshl_b32 s34, s30, 7
    s_add_u32 s34, s34, 12288
    s_add_u32 s40, s28, s34
    s_addc_u32 s41, s29, 0
    v_lshlrev_b32 v7, 7, v1
    s_mov_b64 exec, 15
    s_mov_b64 exec, -1
    s_lshl_b32 s34, s30, 5
    s_add_u32 s34, s34, s31
    s_lshl_b32 s35, s34, 11
    s_add_u32 s35, s35, 327680
    s_add_u32 s42, s28, s35
    s_addc_u32 s43, s29, 0
    s_mul_i32 s35, s31, 1984
    s_sub_u32 s48, s42, s35
    s_subb_u32 s49, s43, 0
    v_lshrrev_b32 v96, 2, v1
    v_lshlrev_b32 v96, 11, v96
    v_and_b32 v104, 3, v1
    v_lshl_add_u32 v96, v104, 4, v96
    s_lshl_b32 s34, s30, 10
    s_add_u32 s34, s34, 4096
    s_add_u32 s46, s28, s34
    s_addc_u32 s47, s29, 0
    s_lshr_b32 s34, s31, 4
    s_lshl_b32 s34, s34, 9
    s_add_u32 s44, s46, s34
    s_addc_u32 s45, s47, 0
    s_lshl_b32 s35, s31, 7
    s_add_u32 s35, s35, 851968
    s_add_u32 s52, s28, s35
    s_addc_u32 s53, s29, 0
    s_lshr_b32 s34, s30, 1
    s_lshl_b32 s34, s34, 14
    s_and_b32 s35, s30, 1
    s_lshl_b32 s35, s35, 12
    s_add_u32 s34, s34, s35
    s_add_u32 s50, s52, s34
    s_addc_u32 s51, s53, 0
    s_lshl_b32 s34, s30, 11
    s_add_u32 s34, s34, 16384
    s_add_u32 s40, s28, s34
    s_addc_u32 s41, s29, 0
    s_lshl_b32 s35, s31, 3
    s_add_u32 s54, s40, s35
    s_addc_u32 s55, s41, 0
    v_lshrrev_b32 v98, 2, v1
    v_lshlrev_b32 v98, 4, v98
    v_lshlrev_b32 v99, 4, v3
    v_lshrrev_b32 v104, 1, v6
    v_lshl_add_u32 v99, v104, 14, v99
    v_and_b32 v104, 1, v6
    v_lshl_add_u32 v99, v104, 12, v99
    v_lshrrev_b32 v100, 5, v1
    v_lshlrev_b32 v100, 8, v100
    s_lshl_b32 s34, s31, 5
    v_lshl_add_u32 v101, v3, 2, s34
    v_mov_b32 v102, 0
    s_getreg_b32 s56, hwreg(HW_REG_XCC_ID, 0, 3)
    s_mov_b32 s74, 0x05040100
    s_mov_b32 s75, 0x07060302
    s_mov_b32 s57, 0x3f803f80
    v_add_u32 v4, 131072, v5
    v_lshrrev_b32 v2, 5, v1
    v_lshl_add_u32 v2, v3, 1, v2
    v_lshlrev_b32 v2, 4, v2
    s_waitcnt vmcnt(0) lgkmcnt(0)
    s_mul_i32 s33, s33, 0x9E3779B1
    s_add_u32 s33, s33, 0x7F4A7C15
    v_dot2_f32_bf16 v20, v16, s57, 0
    v_dot2_f32_bf16 v21, v16, v16, 0
    v_dot2_f32_bf16 v20, v17, s57, v20
    v_dot2_f32_bf16 v21, v17, v17, v21
    v_dot2_f32_bf16 v20, v18, s57, v20
    v_dot2_f32_bf16 v21, v18, v18, v21
    v_dot2_f32_bf16 v20, v19, s57, v20
    v_dot2_f32_bf16 v21, v19, v19, v21
    v_lshlrev_b32 v24, 16, v8
    v_and_b32 v25, 0xffff0000, v8
    v_lshlrev_b32 v26, 16, v9
    v_permlane32_swap_b32 v20, v21
    v_add_f32 v20, v20, v21
    v_mov_b32 v21, v20
    v_and_b32 v27, 0xffff0000, v9
    v_lshlrev_b32 v28, 16, v10
    v_permlane16_swap_b32 v20, v21
    v_add_f32 v20, v20, v21
    v_and_b32 v29, 0xffff0000, v10
    v_lshlrev_b32 v30, 16, v11
    v_add_f32_dpp v20, v20, v20 row_ror:8 row_mask:0xf bank_mask:0xf
    v_and_b32 v31, 0xffff0000, v11
    v_lshlrev_b32 v32, 16, v12
    v_add_f32_dpp v20, v20, v20 row_ror:4 row_mask:0xf bank_mask:0xf
    v_and_b32 v33, 0xffff0000, v12
    v_lshlrev_b32 v34, 16, v13
    v_add_f32_dpp v20, v20, v20 row_ror:2 row_mask:0xf bank_mask:0xf
    v_and_b32 v35, 0xffff0000, v13
    v_lshlrev_b32 v36, 16, v14
    v_add_f32_dpp v20, v20, v20 row_ror:1 row_mask:0xf bank_mask:0xf
    v_and_b32 v37, 0xffff0000, v14
    v_mul_f32 v20, 0x3b124925, v20
    v_mul_f32 v21, 1.0, v20
    s_nop 1
    v_permlane32_swap_b32 v20, v21
    v_fma_f32 v21, -v20, v20, v21
    v_max_f32 v21, 0, v21
    v_cvt_pk_bf16_f32 v22, -v20, v21
    v_and_b32 v21, 0xffff0000, v22
    v_add_f32 v21, 0x3727c5ac, v21
    v_cvt_pk_bf16_f32 v21, v21, v21
    v_lshlrev_b32 v21, 16, v21
    v_sqrt_f32 v21, v21
    v_lshlrev_b32 v20, 16, v22
    v_cvt_pk_bf16_f32 v21, v21, v21
    v_lshlrev_b32 v21, 16, v21
    v_rcp_f32 v21, v21
    s_nop 0
    v_pk_add_f32 v[24:25], v[24:25], v[20:21] op_sel_hi:[1,0]
    v_pk_add_f32 v[26:27], v[26:27], v[20:21] op_sel_hi:[1,0]
    v_pk_add_f32 v[28:29], v[28:29], v[20:21] op_sel_hi:[1,0]
    v_pk_add_f32 v[30:31], v[30:31], v[20:21] op_sel_hi:[1,0]
    v_pk_add_f32 v[32:33], v[32:33], v[20:21] op_sel_hi:[1,0]
    v_pk_add_f32 v[34:35], v[34:35], v[20:21] op_sel_hi:[1,0]
    v_pk_add_f32 v[36:37], v[36:37], v[20:21] op_sel_hi:[1,0]
    v_cvt_pk_bf16_f32 v8, v24, v25
    v_cvt_pk_bf16_f32 v9, v26, v27
    v_cvt_pk_bf16_f32 v10, v28, v29
    v_cvt_pk_bf16_f32 v11, v30, v31
    v_cvt_pk_bf16_f32 v12, v32, v33
    v_cvt_pk_bf16_f32 v13, v34, v35
    v_cvt_pk_bf16_f32 v14, v36, v37
    v_lshlrev_b32 v24, 16, v8
    v_and_b32 v25, 0xffff0000, v8
    v_lshlrev_b32 v26, 16, v9
    v_and_b32 v27, 0xffff0000, v9
    v_lshlrev_b32 v28, 16, v10
    v_and_b32 v29, 0xffff0000, v10
    v_lshlrev_b32 v30, 16, v11
    v_and_b32 v31, 0xffff0000, v11
    v_lshlrev_b32 v32, 16, v12
    v_and_b32 v33, 0xffff0000, v12
    v_lshlrev_b32 v34, 16, v13
    v_and_b32 v35, 0xffff0000, v13
    v_lshlrev_b32 v36, 16, v14
    v_and_b32 v37, 0xffff0000, v14
    v_pk_mul_f32 v[24:25], v[24:25], v[20:21] op_sel:[0,1] op_sel_hi:[1,1]
    v_pk_mul_f32 v[26:27], v[26:27], v[20:21] op_sel:[0,1] op_sel_hi:[1,1]
    v_pk_mul_f32 v[28:29], v[28:29], v[20:21] op_sel:[0,1] op_sel_hi:[1,1]
    v_pk_mul_f32 v[30:31], v[30:31], v[20:21] op_sel:[0,1] op_sel_hi:[1,1]
    v_pk_mul_f32 v[32:33], v[32:33], v[20:21] op_sel:[0,1] op_sel_hi:[1,1]
    v_pk_mul_f32 v[34:35], v[34:35], v[20:21] op_sel:[0,1] op_sel_hi:[1,1]
    v_pk_mul_f32 v[36:37], v[36:37], v[20:21] op_sel:[0,1] op_sel_hi:[1,1]
    v_cvt_pk_bf16_f32 v8, v24, v25
    v_cvt_pk_bf16_f32 v9, v26, v27
    v_cvt_pk_bf16_f32 v10, v28, v29
    v_cvt_pk_bf16_f32 v11, v30, v31
    v_cvt_pk_bf16_f32 v12, v32, v33
    v_cvt_pk_bf16_f32 v13, v34, v35
    v_cvt_pk_bf16_f32 v14, v36, v37
    s_xor_b32 s39, s33, s56
    v_mov_b32 v17, s39
    v_mov_b32 v19, s39
    s_mov_b32 s68, 0xff
    s_mov_b32 s69, 0xff
    v_mov_b32 v20, 148104
L_sw:
    ds_read_b32 v21, v20 offset:20
    ds_read_b32 v22, v20 offset:24
    s_waitcnt lgkmcnt(0)
    v_readfirstlane_b32 s34, v21
    s_nop 0
    s_cmp_eq_u32 s34, 4
    s_cbranch_scc0 L_sw
    v_readfirstlane_b32 s36, v22
    s_nop 0
    s_cmp_gt_i32 s36, 0
    s_cselect_b32 s36, 8, 0
    v_xor_b32 v17, s36, v17
    v_xor_b32 v19, s36, v19
    ds_read_b128 v[40:43], v4 offset:0
    ds_read_b128 v[44:47], v4 offset:1024
    ds_read_b128 v[48:51], v4 offset:2048
    ds_read_b128 v[52:55], v4 offset:3072
    s_waitcnt lgkmcnt(2)
    v_perm_b32 v32, v44, v40, s74
    v_perm_b32 v33, v44, v40, s75
    v_perm_b32 v34, v45, v41, s74
    v_perm_b32 v35, v45, v41, s75
    v_perm_b32 v36, v46, v42, s74
    v_perm_b32 v37, v46, v42, s75
    v_perm_b32 v38, v47, v43, s74
    v_perm_b32 v39, v47, v43, s75
    v_dot2_f32_bf16 v24, v32, v8, 0
    v_dot2_f32_bf16 v25, v33, v8, 0
    v_dot2_f32_bf16 v26, v34, v8, 0
    v_dot2_f32_bf16 v27, v35, v8, 0
    v_dot2_f32_bf16 v28, v36, v8, 0
    v_dot2_f32_bf16 v29, v37, v8, 0
    v_dot2_f32_bf16 v30, v38, v8, 0
    v_dot2_f32_bf16 v31, v39, v8, 0
    ds_read_b128 v[56:59], v4 offset:4096
    ds_read_b128 v[60:63], v4 offset:5120
    s_waitcnt lgkmcnt(2)
    v_perm_b32 v32, v52, v48, s74
    v_perm_b32 v33, v52, v48, s75
    v_perm_b32 v34, v53, v49, s74
    v_perm_b32 v35, v53, v49, s75
    v_perm_b32 v36, v54, v50, s74
    v_perm_b32 v37, v54, v50, s75
    v_perm_b32 v38, v55, v51, s74
    v_perm_b32 v39, v55, v51, s75
    v_dot2_f32_bf16 v24, v32, v9, v24
    v_dot2_f32_bf16 v25, v33, v9, v25
    v_dot2_f32_bf16 v26, v34, v9, v26
    v_dot2_f32_bf16 v27, v35, v9, v27
    v_dot2_f32_bf16 v28, v36, v9, v28
    v_dot2_f32_bf16 v29, v37, v9, v29
    v_dot2_f32_bf16 v30, v38, v9, v30
    v_dot2_f32_bf16 v31, v39, v9, v31
    ds_read_b128 v[64:67], v4 offset:6144
    ds_read_b128 v[68:71], v4 offset:7168
    s_waitcnt lgkmcnt(2)
    v_perm_b32 v32, v60, v56, s74
    v_perm_b32 v33, v60, v56, s75
    v_perm_b32 v34, v61, v57, s74
    v_perm_b32 v35, v61, v57, s75
    v_perm_b32 v36, v62, v58, s74
    v_perm_b32 v37, v62, v58, s75
    v_perm_b32 v38, v63, v59, s74
    v_perm_b32 v39, v63, v59, s75
    v_dot2_f32_bf16 v24, v32, v10, v24
    v_dot2_f32_bf16 v25, v33, v10, v25
    v_dot2_f32_bf16 v26, v34, v10, v26
    v_dot2_f32_bf16 v27, v35, v10, v27
    v_dot2_f32_bf16 v28, v36, v10, v28
    v_dot2_f32_bf16 v29, v37, v10, v29
    v_dot2_f32_bf16 v30, v38, v10, v30
    v_dot2_f32_bf16 v31, v39, v10, v31
    ds_read_b128 v[72:75], v4 offset:8192
    ds_read_b128 v[76:79], v4 offset:9216
    s_waitcnt lgkmcnt(2)
    v_perm_b32 v32, v68, v64, s74
    v_perm_b32 v33, v68, v64, s75
    v_perm_b32 v34, v69, v65, s74
    v_perm_b32 v35, v69, v65, s75
    v_perm_b32 v36, v70, v66, s74
    v_perm_b32 v37, v70, v66, s75
    v_perm_b32 v38, v71, v67, s74
    v_perm_b32 v39, v71, v67, s75
    v_dot2_f32_bf16 v24, v32, v11, v24
    v_dot2_f32_bf16 v25, v33, v11, v25
    v_dot2_f32_bf16 v26, v34, v11, v26
    v_dot2_f32_bf16 v27, v35, v11, v27
    v_dot2_f32_bf16 v28, v36, v11, v28
    v_dot2_f32_bf16 v29, v37, v11, v29
    v_dot2_f32_bf16 v30, v38, v11, v30
    v_dot2_f32_bf16 v31, v39, v11, v31
    ds_read_b128 v[80:83], v4 offset:10240
    ds_read_b128 v[84:87], v4 offset:11264
    s_waitcnt lgkmcnt(2)
    v_perm_b32 v32, v76, v72, s74
    v_perm_b32 v33, v76, v72, s75
    v_perm_b32 v34, v77, v73, s74
    v_perm_b32 v35, v77, v73, s75
    v_perm_b32 v36, v78, v74, s74
    v_perm_b32 v37, v78, v74, s75
    v_perm_b32 v38, v79, v75, s74
    v_perm_b32 v39, v79, v75, s75
    v_dot2_f32_bf16 v24, v32, v12, v24
    v_dot2_f32_bf16 v25, v33, v12, v25
    v_dot2_f32_bf16 v26, v34, v12, v26
    v_dot2_f32_bf16 v27, v35, v12, v27
    v_dot2_f32_bf16 v28, v36, v12, v28
    v_dot2_f32_bf16 v29, v37, v12, v29
    v_dot2_f32_bf16 v30, v38, v12, v30
    v_dot2_f32_bf16 v31, v39, v12, v31
    ds_read_b128 v[88:91], v4 offset:12288
    ds_read_b128 v[92:95], v4 offset:13312
    s_waitcnt lgkmcnt(2)
    v_perm_b32 v32, v84, v80, s74
    v_perm_b32 v33, v84, v80, s75
    v_perm_b32 v34, v85, v81, s74
    v_perm_b32 v35, v85, v81, s75
    v_perm_b32 v36, v86, v82, s74
    v_perm_b32 v37, v86, v82, s75
    v_perm_b32 v38, v87, v83, s74
    v_perm_b32 v39, v87, v83, s75
    v_dot2_f32_bf16 v24, v32, v13, v24
    v_dot2_f32_bf16 v25, v33, v13, v25
    v_dot2_f32_bf16 v26, v34, v13, v26
    v_dot2_f32_bf16 v27, v35, v13, v27
    v_dot2_f32_bf16 v28, v36, v13, v28
    v_dot2_f32_bf16 v29, v37, v13, v29
    v_dot2_f32_bf16 v30, v38, v13, v30
    v_dot2_f32_bf16 v31, v39, v13, v31
    s_waitcnt lgkmcnt(0)
    v_perm_b32 v32, v92, v88, s74
    v_perm_b32 v33, v92, v88, s75
    v_perm_b32 v34, v93, v89, s74
    v_perm_b32 v35, v93, v89, s75
    v_perm_b32 v36, v94, v90, s74
    v_perm_b32 v37, v94, v90, s75
    v_perm_b32 v38, v95, v91, s74
    v_perm_b32 v39, v95, v91, s75
    v_dot2_f32_bf16 v24, v32, v14, v24
    v_dot2_f32_bf16 v25, v33, v14, v25
    v_dot2_f32_bf16 v26, v34, v14, v26
    v_dot2_f32_bf16 v27, v35, v14, v27
    v_dot2_f32_bf16 v28, v36, v14, v28
    v_dot2_f32_bf16 v29, v37, v14, v29
    v_dot2_f32_bf16 v30, v38, v14, v30
    v_dot2_f32_bf16 v31, v39, v14, v31
    v_permlane32_swap_b32 v24, v28
    v_permlane32_swap_b32 v25, v29
    v_permlane32_swap_b32 v26, v30
    v_permlane32_swap_b32 v27, v31
    v_add_f32 v24, v24, v28
    v_add_f32 v25, v25, v29
    v_add_f32 v26, v26, v30
    v_add_f32 v27, v27, v31
    v_mov_b32 v28, v24
    v_mov_b32 v29, v25
    v_mov_b32 v30, v26
    v_mov_b32 v31, v27
    v_permlane16_swap_b32 v24, v28
    v_permlane16_swap_b32 v25, v29
    v_permlane16_swap_b32 v26, v30
    v_permlane16_swap_b32 v27, v31
    v_add_f32 v24, v24, v28
    v_add_f32 v25, v25, v29
    v_add_f32 v26, v26, v30
    v_add_f32 v27, v27, v31
    s_mov_b32 s72, 0x07060501
    s_mov_b32 s73, 0x07060502
    s_mov_b32 s74, 0x07060503
    v_add_f32_dpp v24, v24, v24 row_ror:8 row_mask:0xf bank_mask:0xf
    v_add_f32_dpp v25, v25, v25 row_ror:8 row_mask:0xf bank_mask:0xf
    v_add_f32_dpp v26, v26, v26 row_ror:8 row_mask:0xf bank_mask:0xf
    v_add_f32_dpp v27, v27, v27 row_ror:8 row_mask:0xf bank_mask:0xf
    v_perm_b32 v16, v24, v27, s72
    v_perm_b32 v17, v25, v27, s73
    v_perm_b32 v18, v26, v27, s74
    s_mov_b64 exec, s[68:69]
    global_store_dwordx4 v2, v[16:19], s[58:59]
    s_mov_b64 exec, -1
    v_add_u32 v2, 0x20000, v2
    v_add_u32 v4, 148144, v15
    v_add_u32 v95, 0x8000, v96
    v_lshrrev_b32 v7, 5, v1
    v_lshlrev_b32 v8, 2, v7
    v_add_u32 v8, 148096, v8
    s_lshl_b32 s34, s31, 4
    v_lshl_add_u32 v9, v7, 9, s34
    v_and_b32 v11, 3, v1
    v_lshrrev_b32 v13, 4, v1
    v_lshl_add_u32 v13, v11, 2, v13
    v_lshlrev_b32 v13, 1, v13
    v_add_u32 v13, 148400, v13
    v_lshl_add_u32 v14, v11, 1, v7
    v_lshlrev_b32 v14, 4, v14
    v_bfe_u32 v104, v1, 2, 1
    v_lshl_add_u32 v14, v104, 13, v14
    s_lshl_b32 s34, s2, 3
    v_mov_b32 v90, s34
    v_lshlrev_b32 v91, 5, v7
    v_add_u32 v91, 148448, v91
    s_lshl_b32 s34, s31, 5
    s_lshl_b32 s35, s30, 2
    s_add_u32 s34, s34, s35
    v_lshl_add_u32 v92, v7, 1, s34
    v_lshlrev_b32 v15, 1, v15
    v_add_u32 v15, 145408, v15
    s_mov_b32 s67, 0
    s_movk_i32 s64, 0x1000
    s_movk_i32 s65, 0x2000
    s_movk_i32 s66, 0x3000
    v_mov_b32 v20, 148104
L_sg:
    ds_read_b32 v21, v20 offset:28
    s_waitcnt lgkmcnt(0)
    v_readfirstlane_b32 s34, v21
    s_nop 0
    s_cmp_eq_u32 s34, 4
    s_cbranch_scc0 L_sg
    buffer_load_dwordx4 v[24:27], v5, s[60:63], s67 offen offset:0 sc1
    buffer_load_dwordx4 v[28:31], v5, s[60:63], s67 offen offset:1024 sc1
    buffer_load_dwordx4 v[32:35], v5, s[60:63], s67 offen offset:2048 sc1
    buffer_load_dwordx4 v[36:39], v5, s[60:63], s67 offen offset:3072 sc1
    buffer_load_dwordx4 v[40:43], v5, s[60:63], s64 offen offset:0 sc1
    buffer_load_dwordx4 v[44:47], v5, s[60:63], s64 offen offset:1024 sc1
    buffer_load_dwordx4 v[48:51], v5, s[60:63], s64 offen offset:2048 sc1
    buffer_load_dwordx4 v[52:55], v5, s[60:63], s64 offen offset:3072 sc1
    s_mov_b32 s77, 0
    s_branch L_pq_w
L_pq:
    s_cmp_eq_u32 s77, 2
    s_cbranch_scc0 L_ncp
    s_mov_b64 exec, s[68:69]
    global_store_dwordx4 v2, v[16:19], s[58:59] sc1
    s_mov_b64 exec, -1
L_ncp:
    s_cmp_le_u32 s77, 2
    s_cbranch_scc1 L_nsw
    s_xor_b32 s67, s67, 0x20000
    s_xor_b32 s64, s64, 0x20000
    s_xor_b32 s65, s65, 0x20000
    s_xor_b32 s66, s66, 0x20000
L_nsw:
    buffer_load_dwordx4 v[24:27], v5, s[60:63], s67 offen offset:0 sc1
    buffer_load_dwordx4 v[28:31], v5, s[60:63], s67 offen offset:1024 sc1
    buffer_load_dwordx4 v[32:35], v5, s[60:63], s67 offen offset:2048 sc1
    buffer_load_dwordx4 v[36:39], v5, s[60:63], s67 offen offset:3072 sc1
    buffer_load_dwordx4 v[40:43], v5, s[60:63], s64 offen offset:0 sc1
    buffer_load_dwordx4 v[44:47], v5, s[60:63], s64 offen offset:1024 sc1
    buffer_load_dwordx4 v[48:51], v5, s[60:63], s64 offen offset:2048 sc1
    buffer_load_dwordx4 v[52:55], v5, s[60:63], s64 offen offset:3072 sc1
    s_add_u32 s77, s77, 1
    s_cmp_gt_u32 s77, 4194304
    s_cbranch_scc1 L_pq_x
L_pq_w:
    s_waitcnt vmcnt(0)
    v_xor_b32 v27, s39, v27
    v_xor_b32 v31, s39, v31
    v_xor_b32 v35, s39, v35
    v_xor_b32 v39, s39, v39
    v_xor_b32 v43, s39, v43
    v_xor_b32 v47, s39, v47
    v_xor_b32 v51, s39, v51
    v_xor_b32 v55, s39, v55
    v_cmpx_gt_u32 vcc, 16, v27
    v_cmpx_gt_u32 vcc, 16, v31
    v_cmpx_gt_u32 vcc, 16, v35
    v_cmpx_gt_u32 vcc, 16, v39
    v_cmpx_gt_u32 vcc, 16, v43
    v_cmpx_gt_u32 vcc, 16, v47
    v_cmpx_gt_u32 vcc, 16, v51
    v_cmpx_gt_u32 vcc, 16, v55
    s_nop 0
    s_cmp_eq_u64 exec, -1
    s_mov_b64 exec, -1
    s_cbranch_scc0 L_pq
L_pq_x:
    s_mov_b64 exec, -1
    v_or3_b32 v20, v27, v31, v35
    v_or3_b32 v20, v20, v39, v43
    v_or3_b32 v20, v20, v47, v51
    v_or_b32 v20, v20, v55
    v_and_b32 v20, 7, v20
    v_cmp_eq_u32 vcc, 0, v20
    s_nop 0
    s_cmp_eq_u64 vcc, -1
    s_cselect_b32 s3, 1, 0
    s_cbranch_scc1 L_ncp2
    s_mov_b64 exec, s[68:69]
    global_store_dwordx4 v2, v[16:19], s[58:59] sc1
    s_mov_b64 exec, -1
L_ncp2:
    s_mov_b32 s75, 0x0c04000c
    s_mov_b32 s76, 0x04020100
    v_perm_b32 v56, v25, v24, s75
    v_perm_b32 v56, v26, v56, s76
    v_perm_b32 v57, v29, v28, s75
    v_perm_b32 v57, v30, v57, s76
    v_perm_b32 v58, v33, v32, s75
    v_perm_b32 v58, v34, v58, s76
    v_perm_b32 v59, v37, v36, s75
    v_perm_b32 v59, v38, v59, s76
    v_perm_b32 v60, v41, v40, s75
    v_perm_b32 v60, v42, v60, s76
    v_perm_b32 v61, v45, v44, s75
    v_perm_b32 v61, v46, v61, s76
    v_perm_b32 v62, v49, v48, s75
    v_perm_b32 v62, v50, v62, s76
    v_perm_b32 v63, v53, v52, s75
    v_perm_b32 v63, v54, v63, s76
    v_add_f32 v64, v24, v32
    v_add_f32 v72, v40, v48
    v_add_f32 v64, v64, v72
    v_add_f32 v65, v25, v33
    v_add_f32 v72, v41, v49
    v_add_f32 v65, v65, v72
    v_add_f32 v66, v26, v34
    v_add_f32 v72, v42, v50
    v_add_f32 v66, v66, v72
    v_add_f32 v67, v56, v58
    v_add_f32 v72, v60, v62
    v_add_f32 v67, v67, v72
    v_cvt_pk_bf16_f32 v64, v64, v65
    v_cvt_pk_bf16_f32 v65, v66, v67
    v_add_f32 v68, v28, v36
    v_add_f32 v72, v44, v52
    v_add_f32 v68, v68, v72
    v_add_f32 v69, v29, v37
    v_add_f32 v72, v45, v53
    v_add_f32 v69, v69, v72
    v_add_f32 v70, v30, v38
    v_add_f32 v72, v46, v54
    v_add_f32 v70, v70, v72
    v_add_f32 v71, v57, v59
    v_add_f32 v72, v61, v63
    v_add_f32 v71, v71, v72
    v_cvt_pk_bf16_f32 v68, v68, v69
    v_cvt_pk_bf16_f32 v69, v70, v71
    v_mov_b32 v20, 148104
    v_mov_b32 v21, s3
    ds_write_b64 v15, v[64:65]
    ds_write_b64 v15, v[68:69] offset:576
    ds_write_b32 v20, v21
    v_mov_b32 v21, 1
    s_waitcnt lgkmcnt(0)
    ds_write_b32 v20, v21 offset:4
    s_mov_b32 s38, 0
    v_cmp_lt_u32 vcc, 7, v27
    s_nop 0
    s_bcnt1_i32_b64 s34, vcc
    s_add_u32 s38, s38, s34
    v_cmp_lt_u32 vcc, 7, v31
    s_nop 0
    s_bcnt1_i32_b64 s34, vcc
    s_add_u32 s38, s38, s34
    v_cmp_lt_u32 vcc, 7, v35
    s_nop 0
    s_bcnt1_i32_b64 s34, vcc
    s_add_u32 s38, s38, s34
    v_cmp_lt_u32 vcc, 7, v39
    s_nop 0
    s_bcnt1_i32_b64 s34, vcc
    s_add_u32 s38, s38, s34
    v_cmp_lt_u32 vcc, 7, v43
    s_nop 0
    s_bcnt1_i32_b64 s34, vcc
    s_add_u32 s38, s38, s34
    v_cmp_lt_u32 vcc, 7, v47
    s_nop 0
    s_bcnt1_i32_b64 s34, vcc
    s_add_u32 s38, s38, s34
    v_cmp_lt_u32 vcc, 7, v51
    s_nop 0
    s_bcnt1_i32_b64 s34, vcc
    s_add_u32 s38, s38, s34
    v_cmp_lt_u32 vcc, 7, v55
    s_nop 0
    s_bcnt1_i32_b64 s34, vcc
    s_add_u32 s38, s38, s34
    s_cmp_gt_u32 s38, 176
    s_cselect_b32 s34, 0x2000, 0
    v_add_u32 v99, s34, v99
    v_mov_b32 v18, s33
    s_mov_b32 s68, 1
    s_mov_b32 s69, 1
    s_mov_b32 s70, 0x000f000f
    s_mov_b32 s71, 0x000f000f
    s_mov_b32 s72, 255
    s_mov_b32 s73, 255
    s_mov_b32 s74, 0x3db8aa3b
    s_mov_b32 s75, 0x0c04000c
    s_mov_b32 s76, 0x04020100
    s_mov_b32 s64, -1
    s_mov_b32 s65, 0x00ffffff
    buffer_load_dword v101, v101, s[4:7], 0 offen
    global_load_ushort v103, v102, s[22:23]
    s_min_u32 s34, s31, 27
    s_lshl_b32 s34, s34, 7
    v_mov_b32 v104, s34
    s_mov_b64 exec, 1
    global_load_dword v105, v104, s[16:17]
    global_load_dword v105, v104, s[18:19]
    global_load_dword v105, v104, s[20:21]
    s_mov_b64 exec, -1
    global_load_dwordx4 v[104:107], v5, s[42:43] sc1
    global_load_dwordx4 v[104:107], v5, s[42:43] offset:1024 sc1
    global_load_dwordx4 v[104:107], v98, s[44:45] sc1
    global_load_dwordx4 v[104:107], v98, s[44:45] offset:256 sc1
    global_load_dwordx4 v[104:107], v99, s[52:53] sc1
    global_load_dwordx2 v[104:105], v100, s[54:55] sc1
    s_mov_b64 exec, 1
    global_load_dword v104, v102, s[12:13]
    v_min_u32 v22, 0x37c, v92
    global_load_dword v104, v22, s[24:25]
    s_mov_b64 exec, -1
L_ss:
    ds_read_b32 v21, v20 offset:16
    ds_read_b32 v19, v20 offset:24
    ds_read_b32 v17, v4
    ds_read_b32 v16, v8
    s_waitcnt lgkmcnt(0)
    v_readfirstlane_b32 s34, v21
    s_nop 0
    s_cmp_eq_u32 s34, 8
    s_cbranch_scc0 L_ss
    v_mov_b32 v21, v17
    s_nop 1
    v_permlane16_swap_b32 v17, v21
    v_add_f32 v17, v17, v21
    s_nop 1
    v_add_f32_dpp v17, v17, v17 row_ror:8 row_mask:0xf bank_mask:0xf
    s_nop 1
    v_add_f32_dpp v17, v17, v17 row_ror:4 row_mask:0xf bank_mask:0xf
    s_nop 1
    v_add_f32_dpp v17, v17, v17 row_ror:2 row_mask:0xf bank_mask:0xf
    s_nop 1
    v_add_f32_dpp v17, v17, v17 row_ror:1 row_mask:0xf bank_mask:0xf
    s_mov_b64 exec, s[68:69]
    s_cmp_lg_u32 s3, 0
    s_cbranch_scc0 L_pl3
    global_store_dwordx4 v9, v[16:19], s[46:47]
L_pd3:
    s_mov_b64 exec, -1
    s_nop 0
    v_mov_b32 v17, s33
    v_mov_b32 v19, s33
    s_barrier
    global_load_dwordx4 v[72:75], v98, s[44:45] offset:0 sc1
    global_load_dwordx4 v[76:79], v98, s[44:45] offset:256 sc1
    s_barrier
    s_barrier
    s_mov_b32 s77, 0
    global_load_dwordx4 v[40:43], v5, s[42:43] offset:0 sc1
    global_load_dwordx4 v[44:47], v5, s[42:43] offset:1024 sc1
    s_waitcnt vmcnt(2)
L_ps:
    v_cmpx_eq_u32 vcc, s33, v74
    v_cmpx_eq_u32 vcc, s33, v78
    s_cmp_eq_u64 exec, -1
    s_cbranch_scc0 L_ps2
L_psd:
    v_max_f32 v20, v72, v76
    s_nop 1
    v_max_f32_dpp v20, v20, v20 row_ror:4 row_mask:0xf bank_mask:0xf
    s_nop 1
    v_max_f32_dpp v20, v20, v20 row_ror:8 row_mask:0xf bank_mask:0xf
    v_mov_b32 v21, v20
    s_nop 1
    v_permlane16_swap_b32 v20, v21
    v_max_f32 v20, v20, v21
    v_mov_b32 v21, v20
    s_nop 1
    v_permlane32_swap_b32 v20, v21
    v_max_f32 v20, v20, v21
    v_sub_f32 v22, v72, v20
    v_sub_f32 v23, v76, v20
    v_mul_f32 v22, s74, v22
    v_mul_f32 v23, s74, v23
    v_exp_f32 v22, v22
    v_exp_f32 v23, v23
    v_mul_f32 v20, v22, v73
    v_fmac_f32 v20, v23, v77
    s_nop 1
    v_add_f32_dpp v20, v20, v20 row_ror:4 row_mask:0xf bank_mask:0xf
    s_nop 1
    v_add_f32_dpp v20, v20, v20 row_ror:8 row_mask:0xf bank_mask:0xf
    v_mov_b32 v21, v20
    s_nop 1
    v_permlane16_swap_b32 v20, v21
    v_add_f32 v20, v20, v21
    v_mov_b32 v21, v20
    s_nop 1
    v_permlane32_swap_b32 v20, v21
    v_add_f32 v20, v20, v21
    v_rcp_f32 v20, v20
    s_nop 0
    v_mul_f32 v22, v22, v20
    v_mul_f32 v23, v23, v20
L_po:
    s_mov_b64 exec, -1
    global_load_dwordx4 v[48:51], v5, s[42:43] offset:0 sc1
    global_load_dwordx4 v[52:55], v5, s[42:43] offset:1024 sc1
    s_add_u32 s77, s77, 1
    s_cmp_gt_u32 s77, 4194304
    s_cbranch_scc1 L_po_a
    s_waitcnt vmcnt(2)
    v_cmpx_eq_u32 vcc, s33, v43
    v_cmpx_eq_u32 vcc, s33, v47
    s_cmp_eq_u64 exec, -1
    s_cbranch_scc1 L_po_a
    s_mov_b64 exec, -1
    global_load_dwordx4 v[40:43], v5, s[42:43] offset:0 sc1
    global_load_dwordx4 v[44:47], v5, s[42:43] offset:1024 sc1
    s_waitcnt vmcnt(2)
    v_cmpx_eq_u32 vcc, s33, v51
    v_cmpx_eq_u32 vcc, s33, v55
    s_cmp_eq_u64 exec, -1
    s_cbranch_scc0 L_po
    v_perm_b32 v27, v49, v48, s75
    v_perm_b32 v31, v53, v52, s75
    v_mul_f32 v24, v22, v48
    v_mul_f32 v26, v22, v50
    v_perm_b32 v27, v50, v27, s76
    v_perm_b32 v31, v54, v31, s76
    v_fmac_f32 v24, v23, v52
    v_fmac_f32 v26, v23, v54
    v_mul_f32 v25, v22, v49
    v_mul_f32 v27, v22, v27
    v_fmac_f32 v25, v23, v53
    v_fmac_f32 v27, v23, v31
    s_branch L_po_d
L_po_a:
    v_perm_b32 v27, v41, v40, s75
    v_perm_b32 v31, v45, v44, s75
    v_mul_f32 v24, v22, v40
    v_mul_f32 v26, v22, v42
    v_perm_b32 v27, v42, v27, s76
    v_perm_b32 v31, v46, v31, s76
    v_fmac_f32 v24, v23, v44
    v_fmac_f32 v26, v23, v46
    v_mul_f32 v25, v22, v41
    v_mul_f32 v27, v22, v27
    v_fmac_f32 v25, v23, v45
    v_fmac_f32 v27, v23, v31
L_po_d:
    v_permlane32_swap_b32 v24, v26
    s_nop 0
    v_permlane32_swap_b32 v25, v27
    v_add_f32 v24, v24, v26
    v_add_f32 v25, v25, v27
    s_nop 1
    v_permlane16_swap_b32 v24, v25
    v_add_f32 v24, v24, v25
    s_nop 1
    v_add_f32_dpp v24, v24, v24 row_ror:8 row_mask:0xf bank_mask:0xf
    s_nop 1
    v_add_f32_dpp v24, v24, v24 row_ror:4 row_mask:0xf bank_mask:0xf
    v_cvt_pk_bf16_f32 v24, v24, v24
    s_mov_b64 exec, s[70:71]
    ds_write_b16 v13, v24
    s_mov_b64 exec, -1
    s_waitcnt lgkmcnt(0)
    s_barrier
    s_cmp_ge_u32 s2, 224
    s_cbranch_scc1 L_send
    s_xor_b32 s33, s33, 0x5a5a5a5a
    s_mov_b32 s77, 0
    global_load_dwordx4 v[72:75], v96, s[48:49] sc1
    global_load_dwordx4 v[76:79], v95, s[48:49] sc1
L_pa:
    s_mov_b64 exec, -1
    global_load_dwordx4 v[80:83], v96, s[48:49] sc1
    global_load_dwordx4 v[84:87], v95, s[48:49] sc1
    s_add_u32 s77, s77, 1
    s_cmp_gt_u32 s77, 4194304
    s_cbranch_scc1 L_pa_a
    s_waitcnt vmcnt(2)
    v_cmpx_eq_u32 vcc, s33, v75
    v_cmpx_eq_u32 vcc, s33, v79
    s_cmp_eq_u64 exec, -1
    s_cbranch_scc1 L_pa_a
    s_mov_b64 exec, -1
    global_load_dwordx4 v[72:75], v96, s[48:49] sc1
    global_load_dwordx4 v[76:79], v95, s[48:49] sc1
    s_waitcnt vmcnt(2)
    v_cmpx_eq_u32 vcc, s33, v83
    v_cmpx_eq_u32 vcc, s33, v87
    s_cmp_eq_u64 exec, -1
    s_cbranch_scc0 L_pa
    v_perm_b32 v27, v81, v80, s75
    v_perm_b32 v27, v82, v27, s76
    v_perm_b32 v31, v85, v84, s75
    v_perm_b32 v31, v86, v31, s76
    v_add_f32 v24, v80, v84
    v_add_f32 v25, v81, v85
    v_add_f32 v26, v82, v86
    v_add_f32 v27, v27, v31
    s_branch L_pa_d
L_pa_a:
    v_perm_b32 v27, v73, v72, s75
    v_perm_b32 v27, v74, v27, s76
    v_perm_b32 v31, v77, v76, s75
    v_perm_b32 v31, v78, v31, s76
    v_add_f32 v24, v72, v76
    v_add_f32 v25, v73, v77
    v_add_f32 v26, v74, v78
    v_add_f32 v27, v27, v31
L_pa_d:
    s_xor_b32 s33, s33, 0x5a5a5a5a
    v_permlane32_swap_b32 v24, v26
    v_permlane32_swap_b32 v25, v27
    v_add_f32 v24, v24, v26
    v_add_f32 v25, v25, v27
    s_nop 1
    v_permlane16_swap_b32 v24, v25
    v_add_f32 v24, v24, v25
    s_nop 1
    v_add_f32_dpp v24, v24, v24 row_ror:8 row_mask:0xf bank_mask:0xf
    s_nop 1
    v_add_f32_dpp v24, v24, v24 row_ror:4 row_mask:0xf bank_mask:0xf
    v_mov_b32 v16, v24
    v_mov_b32 v18, v24
    s_nop 1
    v_permlane16_swap_b32 v16, v18
    s_mov_b64 exec, s[72:73]
    global_store_dwordx4 v14, v[16:19], s[50:51] sc1
    s_barrier
    s_mov_b64 exec, -1
    s_mov_b32 s77, 0
    global_load_dwordx4 v[40:43], v99, s[52:53] sc1
    v_lshlrev_b32 v20, 16, v101
    v_and_b32 v21, 0xffff0000, v101
    v_mov_b32 v97, 148432
L_pb:
    s_mov_b64 exec, -1
    global_load_dwordx4 v[44:47], v99, s[52:53] sc1
    s_add_u32 s77, s77, 1
    s_cmp_gt_u32 s77, 4194304
    s_cbranch_scc1 L_pb_a
    s_waitcnt vmcnt(1)
    v_cmpx_eq_u32 vcc, s33, v41
    v_cmpx_eq_u32 vcc, s33, v43
    s_cmp_eq_u64 exec, -1
    s_cbranch_scc1 L_pb_a
    s_mov_b64 exec, -1
    global_load_dwordx4 v[40:43], v99, s[52:53] sc1
    s_waitcnt vmcnt(1)
    v_cmpx_eq_u32 vcc, s33, v45
    v_cmpx_eq_u32 vcc, s33, v47
    s_cmp_eq_u64 exec, -1
    s_cbranch_scc0 L_pb
    v_mov_b32 v24, v44
    v_mov_b32 v26, v46
    s_branch L_pb_d
L_pb_a:
    v_mov_b32 v24, v40
    v_mov_b32 v26, v42
L_pb_d:
    s_nop 1
    v_permlane32_swap_b32 v24, v26
    v_add_f32 v24, v24, v26
    v_mov_b32 v26, v24
    s_nop 1
    v_permlane16_swap_b32 v24, v26
    v_add_f32 v24, v24, v26
    s_nop 1
    v_add_f32_dpp v24, v24, v24 row_ror:8 row_mask:0xf bank_mask:0xf
    v_mov_b32 v26, v24
    s_nop 1
    v_permlane32_swap_b32 v24, v26
    v_cvt_pk_bf16_f32 v24, v24, v26
    v_lshlrev_b32 v22, 16, v24
    v_and_b32 v23, 0xffff0000, v24
    v_pk_add_f32 v[20:21], v[20:21], v[22:23]
    v_cvt_pk_bf16_f32 v22, v20, v21
    v_dot2_f32_bf16 v16, v22, s57, 0
    v_dot2_f32_bf16 v18, v22, v22, 0
    s_lshl_b32 s34, 1, s30
    s_mov_b32 s35, 0
    s_nop 0
    v_permlane32_swap_b32 v16, v18
    s_mov_b64 exec, s[34:35]
    ds_write_b32 v97, v22
    s_mov_b64 exec, -1
    v_add_f32_dpp v16, v16, v16 quad_perm:[1,0,3,2] row_mask:0xf bank_mask:0xf
    s_nop 1
    v_add_f32_dpp v16, v16, v16 quad_perm:[2,3,0,1] row_mask:0xf bank_mask:0xf
    s_nop 1
    v_add_f32_dpp v16, v16, v16 row_ror:4 row_mask:0xf bank_mask:0xf
    s_mov_b64 exec, s[68:69]
    s_cmp_lg_u32 s3, 0
    s_cbranch_scc0 L_pl4
    global_store_dwordx2 v100, v[16:17], s[54:55]
L_pd4:
    s_waitcnt lgkmcnt(0)
    s_barrier
    v_readlane_b32 s34, v22, s30
    v_lshlrev_b32 v103, 16, v103
    v_cmp_lt_u32 vcc, 31, v1
    s_lshl_b32 s35, s34, 16
    s_and_b32 s34, s34, 0xffff0000
    v_mov_b32 v34, s35
    v_mov_b32 v35, s34
    v_cndmask_b32 v34, v34, v35, vcc
    v_add_f32 v34, v34, v103
    s_barrier
    ds_read_b128 v[24:27], v91
    s_waitcnt lgkmcnt(0)
    v_add_f32 v24, v24, v25
    v_add_f32 v26, v26, v27
    v_add_f32 v24, v24, v34
    v_add_f32 v24, v24, v26
    v_cvt_pk_bf16_f32 v24, v24, v24
    global_store_short v92, v24, s[24:25]
    s_cmp_lg_u32 s2, 0
    s_cbranch_scc1 L_noep
    s_mov_b64 exec, 1
    global_store_dword v102, v17, s[28:29]
L_noep:
L_send:
    s_endpgm
L_kv2:
    v_and_b32 v2, 15, v1
    v_lshrrev_b32 v3, 4, v1
    s_lshl_b32 s34, s32, 13
    v_xor_b32 v6, v3, v2
    v_lshlrev_b32 v6, 4, v6
    v_lshl_add_u32 v6, v2, 9, v6
    v_add_u32 v6, s34, v6
    v_xor_b32 v7, 64, v6
    v_xor_b32 v8, 0x80, v6
    v_xor_b32 v9, 0xc0, v6
    v_and_b32 v4, 1, v2
    v_mul_u32_u24 v10, 576, v4
    v_lshl_add_u32 v10, v3, 4, v10
    v_add_u32 v10, 145408, v10
    v_lshlrev_b32 v11, 2, v4
    v_add_u32 v11, 148096, v11
    s_lshl_b32 s34, s32, 4
    s_add_u32 s34, s34, 148144
    v_lshlrev_b32 v12, 7, v4
    v_lshl_add_u32 v12, v3, 2, v12
    v_add_u32 v12, s34, v12
    v_lshrrev_b32 v21, 2, v2
    v_lshlrev_b32 v17, 4, v4
    v_add_u32 v17, v17, v21
    v_lshl_add_u32 v17, s32, 1, v17
    v_lshlrev_b32 v17, 11, v17
    v_lshl_add_u32 v17, v3, 4, v17
    v_lshl_add_u32 v20, s32, 2, v21
    v_lshlrev_b32 v20, 6, v20
    v_lshl_add_u32 v20, v3, 4, v20
    v_and_b32 v4, 3, v2
    v_mul_u32_u24 v13, 320, v4
    v_lshl_add_u32 v13, v3, 4, v13
    v_add_u32 v13, 146560, v13
    s_lshr_b32 s34, s32, 1
    s_lshl_b32 s34, s34, 6
    s_and_b32 s72, s32, 1
    s_lshl_b32 s72, s72, 3
    s_add_u32 s34, s34, s72
    v_add_u32 v14, s34, v13
    v_mov_b32 v4, 147840
    v_cmp_eq_u32 vcc, 1, v21
    s_nop 1
    v_cndmask_b32 v23, v4, v13, vcc
    v_cmp_eq_u32 vcc, 0, v21
    s_nop 1
    v_cndmask_b32 v13, v4, v13, vcc
    v_and_b32 v19, 1, v3
    v_lshlrev_b32 v19, 4, v19
    v_add_u32 v19, 148400, v19
    v_lshrrev_b32 v98, 1, v3
    v_cmp_eq_u32 vcc, v98, v21
    s_nop 1
    v_cndmask_b32 v96, v4, v19, vcc
    v_add_u32 v98, 2, v98
    v_cmp_eq_u32 vcc, v98, v21
    s_nop 1
    v_cndmask_b32 v97, v4, v19, vcc
    v_lshrrev_b32 v4, 2, v1
    v_and_b32 v21, 7, v4
    v_lshlrev_b32 v21, 1, v21
    v_bfe_u32 v15, v1, 1, 1
    v_lshl_add_u32 v15, s32, 2, v15
    v_xor_b32 v15, v15, v21
    v_lshlrev_b32 v15, 4, v15
    v_lshl_add_u32 v15, v4, 9, v15
    v_and_b32 v21, 1, v1
    v_lshl_add_u32 v15, v21, 3, v15
    v_add_u32 v15, 65536, v15
    v_xor_b32 v16, 32, v15
    s_lshl_b32 s62, s32, 11
    s_add_u32 s62, s62, 131072
    v_and_b32 v21, 3, v1
    v_bfe_u32 v19, v1, 2, 2
    v_and_b32 v98, 1, v3
    v_lshl_add_u32 v19, v98, 3, v19
    v_lshlrev_b32 v19, 7, v19
    v_lshl_add_u32 v19, v21, 3, v19
    v_lshrrev_b32 v98, 1, v3
    v_lshl_add_u32 v19, v98, 5, v19
    v_add_u32 v19, s62, v19
    s_lshl_b32 s34, s30, 16
    s_lshl_b32 s72, s31, 6
    s_add_u32 s34, s34, s72
    s_add_u32 s34, s34, 327680
    s_add_u32 s64, s28, s34
    s_addc_u32 s65, s29, 0
    s_mul_i32 s34, s31, 1984
    s_add_u32 s66, s64, s34
    s_addc_u32 s67, s65, 0
    s_mov_b32 s68, 0x00030003
    s_mov_b32 s69, 0x00030003
    s_mov_b32 s70, 0x000f000f
    s_mov_b32 s71, 0x000f000f
    s_mov_b32 s60, 0xcccccccc
    s_mov_b32 s61, 0xcccccccc
    s_mov_b32 s78, 0x3db8aa3b
    s_mov_b32 s72, 0x07060501
    s_mov_b32 s73, 0x07060502
    s_mov_b32 s74, 0x07060503
    v_subrev_u32 v0, 320, v0
    v_mov_b32 v18, 1
    v_lshlrev_b32 v2, 3, v0
    v_mov_b32 v22, 148104
    s_mov_b32 s35, 0
    s_waitcnt lgkmcnt(0)
    s_mul_i32 s33, s33, 0x9E3779B1
    s_add_u32 s33, s33, 0x7F4A7C15
    v_mov_b32 v95, s33
L_sk:
    ds_read_b32 v21, v22 offset:8
    s_waitcnt lgkmcnt(0)
    v_readfirstlane_b32 s34, v21
    s_nop 0
    s_cmp_eq_u32 s34, 4
    s_cbranch_scc0 L_sk
    ds_read_b128 v[24:27], v6 offset:0
    ds_read_b128 v[28:31], v7 offset:0
    ds_read_b128 v[32:35], v8 offset:0
    ds_read_b128 v[36:39], v9 offset:0
    ds_read_b128 v[40:43], v6 offset:256
    ds_read_b128 v[44:47], v7 offset:256
    ds_read_b128 v[48:51], v8 offset:256
    ds_read_b128 v[52:55], v9 offset:256
L_sq:
    ds_read_b64 v[104:105], v22
    s_waitcnt lgkmcnt(0)
    v_readfirstlane_b32 s34, v105
    v_readfirstlane_b32 s3, v104
    s_cmp_eq_u32 s34, 0
    s_cbranch_scc1 L_sq
    ds_read_b128 v[56:59], v10 offset:0
    ds_read_b128 v[60:63], v10 offset:64
    ds_read_b128 v[72:75], v10 offset:128
    ds_read_b128 v[76:79], v10 offset:192
    ds_read_b128 v[80:83], v10 offset:256
    ds_read_b128 v[84:87], v10 offset:320
    ds_read_b128 v[88:91], v10 offset:384
    ds_read_b128 v[100:103], v10 offset:448
    s_waitcnt lgkmcnt(7)
    v_mfma_f32_16x16x32_bf16 v[104:107], v[24:27], v[56:59], 0
    s_waitcnt lgkmcnt(6)
    v_mfma_f32_16x16x32_bf16 v[104:107], v[28:31], v[60:63], v[104:107]
    s_waitcnt lgkmcnt(5)
    v_mfma_f32_16x16x32_bf16 v[104:107], v[32:35], v[72:75], v[104:107]
    s_waitcnt lgkmcnt(4)
    v_mfma_f32_16x16x32_bf16 v[104:107], v[36:39], v[76:79], v[104:107]
    s_waitcnt lgkmcnt(3)
    v_mfma_f32_16x16x32_bf16 v[104:107], v[40:43], v[80:83], v[104:107]
    s_waitcnt lgkmcnt(2)
    v_mfma_f32_16x16x32_bf16 v[104:107], v[44:47], v[84:87], v[104:107]
    s_waitcnt lgkmcnt(1)
    v_mfma_f32_16x16x32_bf16 v[104:107], v[48:51], v[88:91], v[104:107]
    s_waitcnt lgkmcnt(0)
    v_mfma_f32_16x16x32_bf16 v[104:107], v[52:55], v[100:103], v[104:107]
    s_nop 7
    v_cvt_pk_bf16_f32 v24, v104, v105
    v_lshlrev_b32 v88, 16, v24
    v_and_b32 v89, 0xffff0000, v24
    v_cvt_pk_bf16_f32 v25, v106, v107
    v_lshlrev_b32 v90, 16, v25
    v_and_b32 v91, 0xffff0000, v25
    v_max3_f32 v24, v88, v89, v90
    v_max_f32 v24, v24, v91
    s_mov_b64 exec, s[68:69]
    ds_max_f32 v11, v24
    s_mov_b64 exec, 1
    ds_add_u32 v22, v18 offset:12
    s_mov_b64 exec, -1
L_s3:
    ds_read_b32 v25, v22 offset:12
    ds_read_b32 v24, v11
    s_waitcnt lgkmcnt(0)
    v_readfirstlane_b32 s34, v25
    s_nop 0
    s_cmp_eq_u32 s34, 8
    s_cbranch_scc0 L_s3
    v_sub_f32 v88, v88, v24
    v_sub_f32 v89, v89, v24
    v_sub_f32 v90, v90, v24
    v_sub_f32 v91, v91, v24
    v_mul_f32 v88, s78, v88
    v_mul_f32 v89, s78, v89
    v_mul_f32 v90, s78, v90
    v_mul_f32 v91, s78, v91
    v_exp_f32 v88, v88
    v_exp_f32 v89, v89
    v_exp_f32 v90, v90
    v_exp_f32 v91, v91
    v_add_f32 v24, v88, v89
    v_add_f32 v25, v90, v91
    v_add_f32 v24, v24, v25
    v_cvt_pk_bf16_f32 v30, v88, v89
    v_lshlrev_b32 v26, 16, v30
    v_and_b32 v27, 0xffff0000, v30
    v_cvt_pk_bf16_f32 v31, v90, v91
    v_lshlrev_b32 v28, 16, v31
    v_and_b32 v29, 0xffff0000, v31
    v_sub_f32 v26, v88, v26
    v_sub_f32 v27, v89, v27
    v_sub_f32 v28, v90, v28
    v_sub_f32 v29, v91, v29
    v_cndmask_b32 v26, v88, v26, s[60:61]
    v_cndmask_b32 v27, v89, v27, s[60:61]
    v_cndmask_b32 v28, v90, v28, s[60:61]
    v_cndmask_b32 v29, v91, v29, s[60:61]
    v_cvt_pk_bf16_f32 v26, v26, v27
    v_cvt_pk_bf16_f32 v27, v28, v29
    s_mov_b64 exec, s[70:71]
    ds_write_b64 v14, v[26:27]
    s_mov_b64 exec, s[68:69]
    ds_write_b32 v12, v24
    s_mov_b64 exec, -1
    s_mov_b64 exec, 1
    ds_add_u32 v22, v18 offset:16
    s_mov_b64 exec, -1
L_s3b:
    ds_read_b32 v25, v22 offset:16
    s_waitcnt lgkmcnt(0)
    v_readfirstlane_b32 s34, v25
    s_nop 0
    s_cmp_eq_u32 s34, 8
    s_cbranch_scc0 L_s3b
    ds_read_b128 v[56:59], v13 offset:0
    ds_read_b128 v[80:83], v23 offset:0
    ds_read_b128 v[60:63], v13 offset:64
    ds_read_b128 v[84:87], v23 offset:64
    ds_read_b128 v[72:75], v13 offset:128
    ds_read_b128 v[88:91], v23 offset:128
    ds_read_b128 v[76:79], v13 offset:192
    ds_read_b128 v[100:103], v23 offset:192
    s_mov_b32 s68, 0x00330033
    s_mov_b32 s69, 0x00330033
    s_mov_b32 s70, 0x11111111
    s_mov_b32 s71, 0x11111111
    s_mov_b32 s10, 0xbdd2d3e8
    s_mov_b32 s11, 0xbdd2d3e8
    v_lshrrev_b32 v6, 5, v1
    s_lshl_b32 s34, s32, 2
    s_add_u32 s34, s34, 148448
    v_lshlrev_b32 v7, 5, v6
    v_add_u32 v12, s34, v7
    v_mov_b32 v14, 148432
    s_waitcnt lgkmcnt(0)
    s_barrier
    ds_read_b64_tr_b16 v[24:25], v15 offset:0
    ds_read_b64_tr_b16 v[26:27], v15 offset:8192
    ds_read_b64_tr_b16 v[28:29], v16 offset:0
    ds_read_b64_tr_b16 v[30:31], v16 offset:8192
    ds_read_b64_tr_b16 v[32:33], v15 offset:16384
    ds_read_b64_tr_b16 v[34:35], v15 offset:24576
    ds_read_b64_tr_b16 v[36:37], v16 offset:16384
    ds_read_b64_tr_b16 v[38:39], v16 offset:24576
    ds_read_b64_tr_b16 v[40:41], v15 offset:32768
    ds_read_b64_tr_b16 v[42:43], v15 offset:40960
    ds_read_b64_tr_b16 v[44:45], v16 offset:32768
    ds_read_b64_tr_b16 v[46:47], v16 offset:40960
    s_waitcnt lgkmcnt(10)
    v_mfma_f32_16x16x32_bf16 v[104:107], v[24:27], v[56:59], 0
    s_waitcnt lgkmcnt(8)
    v_mfma_f32_16x16x32_bf16 v[104:107], v[28:31], v[80:83], v[104:107]
    s_waitcnt lgkmcnt(6)
    v_mfma_f32_16x16x32_bf16 v[104:107], v[32:35], v[60:63], v[104:107]
    s_waitcnt lgkmcnt(4)
    v_mfma_f32_16x16x32_bf16 v[104:107], v[36:39], v[84:87], v[104:107]
    s_waitcnt lgkmcnt(2)
    v_mfma_f32_16x16x32_bf16 v[104:107], v[40:43], v[72:75], v[104:107]
    s_waitcnt lgkmcnt(0)
    v_mfma_f32_16x16x32_bf16 v[104:107], v[44:47], v[88:91], v[104:107]
    s_barrier
    ds_read_b64_tr_b16 v[48:49], v15 offset:49152
    ds_read_b64_tr_b16 v[50:51], v15 offset:57344
    ds_read_b64_tr_b16 v[52:53], v16 offset:49152
    ds_read_b64_tr_b16 v[54:55], v16 offset:57344
    s_waitcnt lgkmcnt(2)
    v_mfma_f32_16x16x32_bf16 v[104:107], v[48:51], v[76:79], v[104:107]
    s_waitcnt lgkmcnt(0)
    v_mfma_f32_16x16x32_bf16 v[104:107], v[52:55], v[100:103], v[104:107]
    s_nop 7
    v_add_f32_dpp v104, v104, v104 quad_perm:[2,3,0,1] row_mask:0xf bank_mask:0xf
    v_add_f32_dpp v105, v105, v105 quad_perm:[2,3,0,1] row_mask:0xf bank_mask:0xf
    v_add_f32_dpp v106, v106, v106 quad_perm:[2,3,0,1] row_mask:0xf bank_mask:0xf
    v_add_f32_dpp v107, v107, v107 quad_perm:[2,3,0,1] row_mask:0xf bank_mask:0xf
    v_perm_b32 v92, v104, v107, s72
    v_perm_b32 v93, v105, v107, s73
    v_perm_b32 v94, v106, v107, s74
    s_mov_b64 exec, s[68:69]
    s_cmp_lg_u32 s3, 0
    s_cbranch_scc0 L_pl1
    global_store_dwordx4 v17, v[92:95], s[64:65]
L_pd1:
    s_barrier
    s_mov_b64 exec, -1
    s_cmp_eq_u32 s32, 7
    s_cbranch_scc1 L_kend
    v_xor_b32 v95, 0x5a5a5a5a, v95
    v_mov_b32 v48, 0xc0135761
    v_mov_b32 v49, 0xc0135761
    v_mov_b32 v50, 1.0
    v_mov_b32 v51, 1.0
L_swo:
    ds_read_b32 v25, v22 offset:8
    s_waitcnt lgkmcnt(0)
    v_readfirstlane_b32 s34, v25
    s_nop 0
    s_cmp_eq_u32 s34, 8
    s_cbranch_scc0 L_swo
    ds_read_b64_tr_b16 v[24:25], v19 offset:0
    ds_read_b64_tr_b16 v[26:27], v19 offset:512
    ds_read_b64_tr_b16 v[28:29], v19 offset:64
    ds_read_b64_tr_b16 v[30:31], v19 offset:576
    s_waitcnt lgkmcnt(0)
    s_barrier
    ds_read_b128 v[32:35], v96
    ds_read_b128 v[36:39], v97
    s_waitcnt lgkmcnt(1)
    v_mfma_f32_16x16x32_bf16 v[104:107], v[24:27], v[32:35], 0
    s_waitcnt lgkmcnt(0)
    v_mfma_f32_16x16x32_bf16 v[104:107], v[28:31], v[36:39], v[104:107]
    s_nop 7
    v_perm_b32 v92, v104, v107, s72
    v_perm_b32 v93, v105, v107, s73
    v_perm_b32 v94, v106, v107, s74
    s_mov_b64 exec, s[70:71]
    s_cmp_lg_u32 s3, 0
    s_cbranch_scc0 L_pl2
    global_store_dwordx4 v20, v[92:95], s[66:67]
L_pd2:
    s_mov_b64 exec, -1
L_ng:
    s_cmp_ge_u32 s2, 224
    s_cbranch_scc1 L_kend
    s_cmp_ge_u32 s32, 4
    s_cbranch_scc1 L_kend
    s_lshl_b32 s35, s32, 2
    s_lshr_b32 s34, 0xb740, s35
    s_and_b32 s34, s34, 15
    s_lshr_b32 s35, 0xaa33, s35
    s_and_b32 s35, s35, 15
    s_lshl_b32 s34, s34, 8
    s_lshl_b32 s35, s35, 8
    v_mul_u32_u24 v2, 12, v1
    v_add_u32 v2, s34, v2
    v_lshl_add_u32 v3, v1, 2, s35
    s_mov_b32 s12, 0x00003f80
    s_mov_b32 s13, 0x3f800000
    s_barrier
    global_load_dwordx3 v[24:26], v2, s[16:17]
    global_load_dword v27, v3, s[16:17]
    global_load_dwordx3 v[28:30], v2, s[18:19]
    global_load_dword v31, v3, s[18:19]
    global_load_dwordx3 v[32:34], v2, s[20:21]
    global_load_dword v35, v3, s[20:21]
    s_waitcnt vmcnt(0)
    s_mov_b32 s12, 0x3eeff558
    s_mov_b32 s13, 0x40088e99
    v_mov_b32 v48, 0x409d30fc
    v_mov_b32 v49, 0x409d30fc
    v_lshlrev_b32 v52, 16, v24
    v_and_b32 v53, 0xffff0000, v24
    v_mul_f32 v52, s12, v52
    v_mul_f32 v53, s12, v53
    v_lshlrev_b32 v60, 16, v28
    v_and_b32 v61, 0xffff0000, v28
    v_mul_f32 v60, s12, v60
    v_mul_f32 v61, s12, v61
    v_lshlrev_b32 v40, 16, v32
    v_and_b32 v41, 0xffff0000, v32
    v_mul_f32 v40, s13, v40
    v_mul_f32 v41, s13, v41
    v_lshlrev_b32 v54, 16, v25
    v_and_b32 v55, 0xffff0000, v25
    v_mul_f32 v54, s12, v54
    v_mul_f32 v55, s12, v55
    v_lshlrev_b32 v62, 16, v29
    v_and_b32 v63, 0xffff0000, v29
    v_mul_f32 v62, s12, v62
    v_mul_f32 v63, s12, v63
    v_lshlrev_b32 v42, 16, v33
    v_and_b32 v43, 0xffff0000, v33
    v_mul_f32 v42, s13, v42
    v_mul_f32 v43, s13, v43
    v_lshlrev_b32 v56, 16, v26
    v_and_b32 v57, 0xffff0000, v26
    v_mul_f32 v56, s12, v56
    v_mul_f32 v57, s12, v57
    v_lshlrev_b32 v64, 16, v30
    v_and_b32 v65, 0xffff0000, v30
    v_mul_f32 v64, s12, v64
    v_mul_f32 v65, s12, v65
    v_lshlrev_b32 v44, 16, v34
    v_and_b32 v45, 0xffff0000, v34
    v_mul_f32 v44, s13, v44
    v_mul_f32 v45, s13, v45
    v_lshlrev_b32 v58, 16, v27
    v_and_b32 v59, 0xffff0000, v27
    v_mul_f32 v58, s12, v58
    v_mul_f32 v59, s12, v59
    v_lshlrev_b32 v66, 16, v31
    v_and_b32 v67, 0xffff0000, v31
    v_mul_f32 v66, s12, v66
    v_mul_f32 v67, s12, v67
    v_lshlrev_b32 v46, 16, v35
    v_and_b32 v47, 0xffff0000, v35
    v_mul_f32 v46, s13, v46
    v_mul_f32 v47, s13, v47
    s_mov_b32 s68, 1
    s_mov_b32 s69, 1
    s_and_b32 s34, s32, 1
    s_cselect_b32 s8, 0, 1.0
    s_cselect_b32 s9, 1.0, 0
    s_cselect_b64 s[16:17], -1, 0
    v_readfirstlane_b32 s33, v95
    s_lshl_b32 s34, s30, 11
    s_add_u32 s34, s34, 16384
    s_add_u32 s40, s28, s34
    s_addc_u32 s41, s29, 0
    s_xor_b32 s33, s33, 0x5a5a5a5a
    v_lshlrev_b32 v5, 3, v1
    s_mov_b32 s64, 0x0fffffff
    s_mov_b32 s65, 0x0fffffff
    v_mov_b32 v36, 0
    s_mov_b32 s34, 0x3727c5ac
    s_barrier
    ds_read_b32 v35, v14
    s_mov_b32 s77, 0
    s_mov_b64 exec, s[64:65]
    global_load_dwordx2 v[96:97], v5, s[40:41] sc1
    s_waitcnt lgkmcnt(0)
    s_mov_b64 exec, -1
    v_lshlrev_b32 v32, 16, v35
    v_and_b32 v33, 0xffff0000, v35
L_pc2:
    s_mov_b64 exec, s[64:65]
    global_load_dwordx2 v[98:99], v5, s[40:41] sc1
    s_add_u32 s77, s77, 1
    s_cmp_gt_u32 s77, 4194304
    s_cbranch_scc1 L_pc2_a
    s_waitcnt vmcnt(1)
    v_cmpx_eq_u32 vcc, s33, v97
    s_cmp_eq_u64 exec, s[64:65]
    s_cbranch_scc1 L_pc2_a
    s_mov_b64 exec, s[64:65]
    global_load_dwordx2 v[96:97], v5, s[40:41] sc1
    s_waitcnt vmcnt(1)
    v_cmpx_eq_u32 vcc, s33, v99
    s_cmp_eq_u64 exec, s[64:65]
    s_cbranch_scc0 L_pc2
    v_mov_b32 v36, v98
    s_mov_b64 exec, -1
    s_branch L_pc2_d
L_pc2_a:
    v_mov_b32 v36, v96
    s_mov_b64 exec, -1
L_pc2_d:
    v_mov_b32 v37, v36
    s_nop 1
    v_permlane16_swap_b32 v36, v37
    v_add_f32 v36, v36, v37
    s_nop 1
    v_add_f32_dpp v36, v36, v36 row_ror:8 row_mask:0xf bank_mask:0xf
    s_nop 1
    v_add_f32_dpp v36, v36, v36 row_ror:4 row_mask:0xf bank_mask:0xf
    s_nop 1
    v_add_f32_dpp v36, v36, v36 row_ror:2 row_mask:0xf bank_mask:0xf
    s_nop 1
    v_add_f32_dpp v36, v36, v36 row_ror:1 row_mask:0xf bank_mask:0xf
    v_mul_f32 v37, 0x3b124925, v36
    v_mul_f32 v36, 0x3b124925, v36
    s_nop 1
    v_permlane32_swap_b32 v36, v37
    v_fma_f32 v37, -v36, v36, v37
    v_pk_add_f32 v[32:33], v[32:33], v[36:37] op_sel_hi:[1,0] neg_lo:[0,1] neg_hi:[0,1]
    v_max_f32 v37, 0, v37
    v_add_f32 v38, s34, v37
    v_fmac_f32 v37, s34, v38
    v_rsq_f32 v37, v37
    s_nop 0
    v_pk_mul_f32 v[32:33], v[32:33], v[36:37] op_sel:[0,1] op_sel_hi:[1,1]
    v_cndmask_b32 v34, v32, v33, s[16:17]
    v_pk_fma_f32 v[68:69], v[52:53], v[32:33], v[60:61] op_sel:[0,0,0] op_sel_hi:[1,0,1]
    v_pk_fma_f32 v[70:71], v[52:53], v[32:33], v[60:61] op_sel:[0,1,0] op_sel_hi:[1,1,1]
    v_pk_fma_f32 v[72:73], v[54:55], v[32:33], v[62:63] op_sel:[0,0,0] op_sel_hi:[1,0,1]
    v_pk_fma_f32 v[74:75], v[54:55], v[32:33], v[62:63] op_sel:[0,1,0] op_sel_hi:[1,1,1]
    v_pk_fma_f32 v[76:77], v[56:57], v[32:33], v[64:65] op_sel:[0,0,0] op_sel_hi:[1,0,1]
    v_pk_fma_f32 v[78:79], v[56:57], v[32:33], v[64:65] op_sel:[0,1,0] op_sel_hi:[1,1,1]
    v_pk_fma_f32 v[80:81], v[58:59], v[34:35], v[66:67] op_sel:[0,0,0] op_sel_hi:[1,0,1]
    v_pk_fma_f32 v[84:85], v[68:69], v[68:69], v[48:49]
    v_pk_fma_f32 v[86:87], v[70:71], v[70:71], v[48:49]
    v_pk_fma_f32 v[88:89], v[72:73], v[72:73], v[48:49]
    v_pk_fma_f32 v[90:91], v[74:75], v[74:75], v[48:49]
    v_pk_fma_f32 v[92:93], v[76:77], v[76:77], v[48:49]
    v_pk_fma_f32 v[94:95], v[78:79], v[78:79], v[48:49]
    v_pk_fma_f32 v[100:101], v[80:81], v[80:81], v[48:49]
    v_pk_mul_f32 v[84:85], v[84:85], v[68:69]
    v_pk_mul_f32 v[86:87], v[86:87], v[70:71]
    v_pk_mul_f32 v[88:89], v[88:89], v[72:73]
    v_pk_mul_f32 v[90:91], v[90:91], v[74:75]
    v_pk_mul_f32 v[92:93], v[92:93], v[76:77]
    v_pk_mul_f32 v[94:95], v[94:95], v[78:79]
    v_pk_mul_f32 v[100:101], v[100:101], v[80:81]
    v_exp_f32 v84, -v84
    v_exp_f32 v85, -v85
    v_exp_f32 v86, -v86
    v_exp_f32 v87, -v87
    v_exp_f32 v88, -v88
    v_exp_f32 v89, -v89
    v_exp_f32 v90, -v90
    v_exp_f32 v91, -v91
    v_exp_f32 v92, -v92
    v_exp_f32 v93, -v93
    v_exp_f32 v94, -v94
    v_exp_f32 v95, -v95
    v_exp_f32 v100, -v100
    v_exp_f32 v101, -v101
    v_pk_add_f32 v[84:85], v[84:85], v[50:51]
    v_pk_add_f32 v[86:87], v[86:87], v[50:51]
    v_pk_add_f32 v[88:89], v[88:89], v[50:51]
    v_pk_add_f32 v[90:91], v[90:91], v[50:51]
    v_pk_add_f32 v[92:93], v[92:93], v[50:51]
    v_pk_add_f32 v[94:95], v[94:95], v[50:51]
    v_pk_add_f32 v[100:101], v[100:101], v[50:51]
    v_rcp_f32 v84, v84
    v_rcp_f32 v85, v85
    v_rcp_f32 v86, v86
    v_rcp_f32 v87, v87
    v_rcp_f32 v88, v88
    v_rcp_f32 v89, v89
    v_rcp_f32 v90, v90
    v_rcp_f32 v91, v91
    v_rcp_f32 v92, v92
    v_rcp_f32 v93, v93
    v_rcp_f32 v94, v94
    v_rcp_f32 v95, v95
    v_rcp_f32 v100, v100
    v_rcp_f32 v101, v101
    v_pk_mul_f32 v[68:69], v[68:69], v[40:41]
    v_pk_mul_f32 v[70:71], v[70:71], v[40:41]
    v_pk_mul_f32 v[72:73], v[72:73], v[42:43]
    v_pk_mul_f32 v[74:75], v[74:75], v[42:43]
    v_pk_mul_f32 v[76:77], v[76:77], v[44:45]
    v_pk_mul_f32 v[78:79], v[78:79], v[44:45]
    v_pk_mul_f32 v[80:81], v[80:81], v[46:47]
    v_pk_mul_f32 v[28:29], v[80:81], v[100:101]
    v_pk_mul_f32 v[24:25], v[68:69], v[84:85]
    v_pk_mul_f32 v[26:27], v[70:71], v[86:87]
    v_add_f32 v28, v28, v29
    v_pk_fma_f32 v[24:25], v[72:73], v[88:89], v[24:25]
    v_pk_fma_f32 v[26:27], v[74:75], v[90:91], v[26:27]
    v_pk_fma_f32 v[24:25], v[76:77], v[92:93], v[24:25]
    v_pk_fma_f32 v[26:27], v[78:79], v[94:95], v[26:27]
    v_add_f32 v24, v24, v25
    v_add_f32 v25, v26, v27
    v_fmac_f32 v24, s8, v28
    v_fmac_f32 v25, s9, v28
    s_nop 1
    v_permlane32_swap_b32 v24, v25
    v_add_f32 v24, v24, v25
    v_mov_b32 v25, v24
    s_nop 1
    v_permlane16_swap_b32 v24, v25
    v_add_f32 v24, v24, v25
    s_nop 1
    v_add_f32_dpp v24, v24, v24 row_ror:8 row_mask:0xf bank_mask:0xf
    s_nop 1
    v_add_f32_dpp v24, v24, v24 row_ror:4 row_mask:0xf bank_mask:0xf
    s_nop 1
    v_add_f32_dpp v24, v24, v24 row_ror:2 row_mask:0xf bank_mask:0xf
    s_nop 1
    v_add_f32_dpp v24, v24, v24 row_ror:1 row_mask:0xf bank_mask:0xf
    s_mov_b64 exec, s[68:69]
    ds_write_b32 v12, v24
    s_waitcnt lgkmcnt(0)
    s_barrier
L_kend:
L_end:
    s_endpgm
L_pl1:
    global_store_dwordx4 v17, v[92:95], s[64:65] sc1
    s_branch L_pd1
L_pl2:
    global_store_dwordx4 v20, v[92:95], s[66:67] sc1
    s_branch L_pd2
L_pl3:
    global_store_dwordx4 v9, v[16:19], s[46:47] sc1
    s_branch L_pd3
L_ps2:
    s_mov_b64 exec, -1
    global_load_dwordx4 v[72:75], v98, s[44:45] offset:0 sc1
    global_load_dwordx4 v[76:79], v98, s[44:45] offset:256 sc1
    s_add_u32 s77, s77, 1
    s_cmp_gt_u32 s77, 4194304
    s_cbranch_scc1 L_psd
    s_waitcnt vmcnt(0)
    s_branch L_ps
L_pl4:
    global_store_dwordx2 v100, v[16:17], s[54:55] sc1
    s_branch L_pd4
L_codeend:
.section .rodata,"a"
.p2align 6
.amdhsa_kernel sequential_preLN__sliding_block_cached__mixer_token_mlp__decode_kernel
  .amdhsa_next_free_vgpr 108
  .amdhsa_next_free_sgpr 102
  .amdhsa_accum_offset 108
  .amdhsa_group_segment_fixed_size 0
  .amdhsa_kernarg_size 104
  .amdhsa_user_sgpr_count 2
  .amdhsa_user_sgpr_kernarg_segment_ptr 1
  .amdhsa_system_sgpr_workgroup_id_x 1
.end_amdhsa_kernel
```
